```python
import torch

def _softmax(x, axis=-1):
    return torch.softmax(x, dim=axis)
def _gelu(x):
    return torch.nn.functional.gelu(x, approximate="tanh")
def _silu(x):
    return torch.nn.functional.silu(x)
def _sigmoid(x):
    return torch.sigmoid(x)
def _layernorm(x, axis=-1, eps=1e-5):
    m = x.mean(dim=axis, keepdim=True)
    v = x.var(dim=axis, keepdim=True, unbiased=False)
    return (x - m) / torch.sqrt(v + eps)
def _scatter_add(tgt, idx, src, axis=0):
    return tgt.clone().index_add_(axis, idx, src)
def _segment_sum(src, seg, n):
    out = torch.zeros((n,) + src.shape[1:], dtype=src.dtype)
    return out.index_add_(0, seg, src)
def _pad(x, pw):
    flat = tuple(v for pair in reversed(pw) for v in pair)
    return torch.nn.functional.pad(x, flat)

kernel_name = 'gather_scatter__cheap_equivariant_egnn__graph'

def setup_inputs():

    _w = (lambda a: (lambda t: t.to(torch.bfloat16) if t.is_floating_point() else t)(torch.as_tensor(a)))
    N, deg, D, De = 10000, 16, 128, max(4, 1)
    E = N * deg
    return {
        "h": _w((lambda *s: torch.randn(*s, dtype=torch.bfloat16) * 0.2)(N, D)),
        "pos": _w((lambda *s: torch.randn(*s, dtype=torch.bfloat16) * 0.8)(N, 3)),
        "e_attr": _w((lambda *s: torch.randn(*s, dtype=torch.bfloat16) * 0.8)(E, De)),
        "src": _w((lambda lo, hi, *s: torch.randint(lo, hi, s))(0, N, E).to(torch.int64)),
        "dst": _w((lambda lo, hi, *s: torch.randint(lo, hi, s))(0, N, E).to(torch.int64)),
        "w_e": _w(0.1 * (lambda *s: torch.randn(*s, dtype=torch.bfloat16) * 0.8)(2 * D + 1 + De, D)),
        "w_x": _w(0.1 * (lambda *s: torch.randn(*s, dtype=torch.bfloat16) * 0.2)(D, 1)),
        "w_h": _w(0.1 * (lambda *s: torch.randn(*s, dtype=torch.bfloat16) * 0.2)(2 * D, D)),
    }

def reference(h, pos, e_attr, src, dst, w_e, w_x, w_h):
    N, D = h.shape[0], h.shape[1]
    diff = pos[dst] - pos[src]
    dist2 = torch.sum(diff * diff, axis=-1, keepdims=True)
    e_in = torch.concatenate([h[dst], h[src], dist2, e_attr], axis=-1)
    m_ij = _silu(e_in @ w_e)
    coord_scale = m_ij @ w_x
    pos_new = pos + _segment_sum(diff * coord_scale, dst, N)
    m_i = _segment_sum(m_ij, dst, N)
    h_new = h + _silu(torch.concatenate([h, m_i], axis=-1) @ w_h)
    return h_new, pos_new
```

```asm
; @launch kernel=k1_kernel grid=(494,1,1) block=(256,1,1) lds=2048
; @launch kernel=k2_kernel grid=(250,1,1) block=(1024,1,1) lds=136544
.amdgcn_target "amdgcn-amd-amdhsa--gfx950"
.text
.globl k1_kernel
.p2align 8
.type k1_kernel,@function
k1_kernel:
    s_load_dwordx16 s[16:31], s[0:1], 0
    s_load_dwordx2 s[32:33], s[0:1], 80
    s_load_dwordx2 s[34:35], s[0:1], 64
    s_waitcnt lgkmcnt(0)
    s_cmp_ge_u32 s2, 313
    s_cbranch_scc1 K1_G
    s_lshl_b32 s3, s2, 9
    v_lshl_add_u32 v1, v0, 1, s3
    v_lshlrev_b32 v2, 2, v0
    v_mov_b32 v3, 0
    ds_write_b32 v2, v3
    s_waitcnt lgkmcnt(0)
    s_barrier
    s_mov_b32 s4, 160000
    v_cmp_gt_u32 vcc, s4, v1
    s_and_saveexec_b64 s[6:7], vcc
    s_cbranch_execz P_s1
    v_lshlrev_b32 v4, 2, v1
    v_lshlrev_b32 v5, 3, v1
    global_load_dwordx2 v[6:7], v4, s[24:25]
    global_load_dwordx2 v[8:9], v4, s[22:23]
    global_load_dwordx4 v[10:13], v5, s[20:21]
    s_waitcnt vmcnt(0)
    v_mul_u32_u24 v14, 6, v6
    v_mul_u32_u24 v15, 6, v8
    global_load_ushort v20, v14, s[18:19] offset:0
    global_load_ushort v23, v15, s[18:19] offset:0
    global_load_ushort v21, v14, s[18:19] offset:2
    global_load_ushort v24, v15, s[18:19] offset:2
    global_load_ushort v22, v14, s[18:19] offset:4
    global_load_ushort v25, v15, s[18:19] offset:4
    v_mul_u32_u24 v14, 6, v7
    v_mul_u32_u24 v15, 6, v9
    global_load_ushort v26, v14, s[18:19] offset:0
    global_load_ushort v29, v15, s[18:19] offset:0
    global_load_ushort v27, v14, s[18:19] offset:2
    global_load_ushort v30, v15, s[18:19] offset:2
    global_load_ushort v28, v14, s[18:19] offset:4
    global_load_ushort v31, v15, s[18:19] offset:4
    v_mul_u32_u24 v32, 0xcccd, v6
    v_lshrrev_b32 v32, 21, v32
    v_mul_u32_u24 v34, 40, v32
    v_sub_u32 v34, v6, v34
    v_lshlrev_b32 v16, 2, v32
    v_mov_b32 v17, 1
    ds_add_rtn_u32 v36, v16, v17
    v_mul_u32_u24 v33, 0xcccd, v7
    v_lshrrev_b32 v33, 21, v33
    v_mul_u32_u24 v35, 40, v33
    v_sub_u32 v35, v7, v35
    v_lshlrev_b32 v16, 2, v33
    v_mov_b32 v17, 1
    ds_add_rtn_u32 v37, v16, v17
    s_waitcnt vmcnt(0)
    v_lshlrev_b32 v20, 16, v20
    v_lshlrev_b32 v23, 16, v23
    v_sub_f32 v20, v20, v23
    v_cvt_pk_bf16_f32 v20, v20, v20
    v_and_b32 v20, 0xffff0000, v20
    v_mul_f32 v23, v20, v20
    v_cvt_pk_bf16_f32 v23, v23, v23
    v_and_b32 v23, 0xffff0000, v23
    v_lshlrev_b32 v21, 16, v21
    v_lshlrev_b32 v24, 16, v24
    v_sub_f32 v21, v21, v24
    v_cvt_pk_bf16_f32 v21, v21, v21
    v_and_b32 v21, 0xffff0000, v21
    v_mul_f32 v24, v21, v21
    v_cvt_pk_bf16_f32 v24, v24, v24
    v_and_b32 v24, 0xffff0000, v24
    v_lshlrev_b32 v22, 16, v22
    v_lshlrev_b32 v25, 16, v25
    v_sub_f32 v22, v22, v25
    v_cvt_pk_bf16_f32 v22, v22, v22
    v_and_b32 v22, 0xffff0000, v22
    v_mul_f32 v25, v22, v22
    v_cvt_pk_bf16_f32 v25, v25, v25
    v_and_b32 v25, 0xffff0000, v25
    v_add_f32 v41, v23, v24
    v_add_f32 v41, v41, v25
    v_cvt_pk_bf16_f32 v41, v41, v41
    v_and_b32 v41, 0xffff0000, v41
    v_lshl_or_b32 v40, v34, 16, v8
    v_mov_b32 v42, v10
    v_mov_b32 v43, v11
    v_lshrrev_b32 v44, 16, v20
    v_or_b32 v44, v44, v21
    v_lshrrev_b32 v45, 16, v22
    v_lshlrev_b32 v26, 16, v26
    v_lshlrev_b32 v29, 16, v29
    v_sub_f32 v26, v26, v29
    v_cvt_pk_bf16_f32 v26, v26, v26
    v_and_b32 v26, 0xffff0000, v26
    v_mul_f32 v29, v26, v26
    v_cvt_pk_bf16_f32 v29, v29, v29
    v_and_b32 v29, 0xffff0000, v29
    v_lshlrev_b32 v27, 16, v27
    v_lshlrev_b32 v30, 16, v30
    v_sub_f32 v27, v27, v30
    v_cvt_pk_bf16_f32 v27, v27, v27
    v_and_b32 v27, 0xffff0000, v27
    v_mul_f32 v30, v27, v27
    v_cvt_pk_bf16_f32 v30, v30, v30
    v_and_b32 v30, 0xffff0000, v30
    v_lshlrev_b32 v28, 16, v28
    v_lshlrev_b32 v31, 16, v31
    v_sub_f32 v28, v28, v31
    v_cvt_pk_bf16_f32 v28, v28, v28
    v_and_b32 v28, 0xffff0000, v28
    v_mul_f32 v31, v28, v28
    v_cvt_pk_bf16_f32 v31, v31, v31
    v_and_b32 v31, 0xffff0000, v31
    v_add_f32 v49, v29, v30
    v_add_f32 v49, v49, v31
    v_cvt_pk_bf16_f32 v49, v49, v49
    v_and_b32 v49, 0xffff0000, v49
    v_lshl_or_b32 v48, v35, 16, v9
    v_mov_b32 v50, v12
    v_mov_b32 v51, v13
    v_lshrrev_b32 v52, 16, v26
    v_or_b32 v52, v52, v27
    v_lshrrev_b32 v53, 16, v28
P_s1:
    s_mov_b64 exec, s[6:7]
    s_waitcnt lgkmcnt(0)
    s_barrier
    ds_read_b32 v60, v2
    s_waitcnt lgkmcnt(0)
    v_mov_b32 v61, v60
    s_nop 1
    v_add_u32_dpp v61, v61, v61 row_shr:1 row_mask:0xf bank_mask:0xf bound_ctrl:0
    s_nop 1
    v_add_u32_dpp v61, v61, v61 row_shr:2 row_mask:0xf bank_mask:0xf bound_ctrl:0
    s_nop 1
    v_add_u32_dpp v61, v61, v61 row_shr:4 row_mask:0xf bank_mask:0xf bound_ctrl:0
    s_nop 1
    v_add_u32_dpp v61, v61, v61 row_shr:8 row_mask:0xf bank_mask:0xf bound_ctrl:0
    s_nop 1
    v_add_u32_dpp v61, v61, v61 row_bcast:15 row_mask:0xa bank_mask:0xf
    s_nop 1
    v_add_u32_dpp v61, v61, v61 row_bcast:31 row_mask:0xc bank_mask:0xf
    s_nop 1
    v_readlane_b32 s8, v61, 63
    v_lshrrev_b32 v62, 6, v0
    v_lshlrev_b32 v63, 2, v62
    v_mov_b32 v64, s8
    ds_write_b32 v63, v64 offset:1024
    s_waitcnt lgkmcnt(0)
    s_barrier
    ds_read_b128 v[64:67], v3 offset:1024
    s_waitcnt lgkmcnt(0)
    v_sub_u32 v61, v61, v60
    v_cmp_lt_u32 vcc, 0, v62
    s_nop 1
    v_cndmask_b32 v68, 0, v64, vcc
    v_add_u32 v61, v61, v68
    v_cmp_lt_u32 vcc, 1, v62
    s_nop 1
    v_cndmask_b32 v68, 0, v65, vcc
    v_add_u32 v61, v61, v68
    v_cmp_lt_u32 vcc, 2, v62
    s_nop 1
    v_cndmask_b32 v68, 0, v66, vcc
    v_add_u32 v61, v61, v68
    s_barrier
    ds_write_b32 v2, v61
    s_lshl_b32 s3, s2, 2
    v_mul_u32_u24 v69, 1280, v0
    v_add_u32 v69, s3, v69
    v_add_u32 v69, 2752512, v69
    global_store_dword v69, v61, s[32:33]
    s_waitcnt lgkmcnt(0)
    s_barrier
    s_mov_b32 s4, 160000
    v_cmp_gt_u32 vcc, s4, v1
    s_and_saveexec_b64 s[6:7], vcc
    s_cbranch_execz K1_end
    v_lshlrev_b32 v16, 2, v32
    ds_read_b32 v70, v16
    v_lshlrev_b32 v16, 2, v33
    ds_read_b32 v71, v16
    s_waitcnt lgkmcnt(0)
    s_mul_i32 s3, s2, 517
    v_add3_u32 v70, v70, v36, s3
    v_lshlrev_b32 v70, 5, v70
    v_add_u32 v70, 3145728, v70
    global_store_dwordx4 v70, v[40:43], s[32:33]
    global_store_dwordx2 v70, v[44:45], s[32:33] offset:16
    v_add3_u32 v71, v71, v37, s3
    v_lshlrev_b32 v71, 5, v71
    v_add_u32 v71, 3145728, v71
    global_store_dwordx4 v71, v[48:51], s[32:33]
    global_store_dwordx2 v71, v[52:53], s[32:33] offset:16
    s_branch K1_end
K1_G:
    s_cmp_ge_u32 s2, 470
    s_cbranch_scc1 K1_T
    s_sub_u32 s3, s2, 313
    s_lshl_b32 s3, s3, 6
    v_and_b32 v1, 31, v0
    v_bfe_u32 v2, v0, 5, 1
    v_lshrrev_b32 v3, 6, v0
    v_lshl_add_u32 v4, v3, 5, v1
    v_lshlrev_b32 v5, 3, v2
    v_add_u32 v6, 128, v5
    v_lshlrev_b32 v6, 8, v6
    v_lshl_add_u32 v6, v4, 1, v6
    global_load_ushort v48, v6, s[26:27] offset:0
    global_load_ushort v49, v6, s[26:27] offset:256
    global_load_ushort v50, v6, s[26:27] offset:512
    global_load_ushort v51, v6, s[26:27] offset:768
    global_load_ushort v52, v6, s[26:27] offset:1024
    global_load_ushort v53, v6, s[26:27] offset:1280
    global_load_ushort v54, v6, s[26:27] offset:1536
    global_load_ushort v55, v6, s[26:27] offset:1792
    v_add_u32 v6, 4096, v6
    global_load_ushort v56, v6, s[26:27] offset:0
    global_load_ushort v57, v6, s[26:27] offset:256
    global_load_ushort v58, v6, s[26:27] offset:512
    global_load_ushort v59, v6, s[26:27] offset:768
    global_load_ushort v60, v6, s[26:27] offset:1024
    global_load_ushort v61, v6, s[26:27] offset:1280
    global_load_ushort v62, v6, s[26:27] offset:1536
    global_load_ushort v63, v6, s[26:27] offset:1792
    v_add_u32 v6, 4096, v6
    global_load_ushort v64, v6, s[26:27] offset:0
    global_load_ushort v65, v6, s[26:27] offset:256
    global_load_ushort v66, v6, s[26:27] offset:512
    global_load_ushort v67, v6, s[26:27] offset:768
    global_load_ushort v68, v6, s[26:27] offset:1024
    global_load_ushort v69, v6, s[26:27] offset:1280
    global_load_ushort v70, v6, s[26:27] offset:1536
    global_load_ushort v71, v6, s[26:27] offset:1792
    v_add_u32 v6, 4096, v6
    global_load_ushort v72, v6, s[26:27] offset:0
    global_load_ushort v73, v6, s[26:27] offset:256
    global_load_ushort v74, v6, s[26:27] offset:512
    global_load_ushort v75, v6, s[26:27] offset:768
    global_load_ushort v76, v6, s[26:27] offset:1024
    global_load_ushort v77, v6, s[26:27] offset:1280
    global_load_ushort v78, v6, s[26:27] offset:1536
    global_load_ushort v79, v6, s[26:27] offset:1792
    v_add_u32 v6, 4096, v6
    global_load_ushort v80, v6, s[26:27] offset:0
    global_load_ushort v81, v6, s[26:27] offset:256
    global_load_ushort v82, v6, s[26:27] offset:512
    global_load_ushort v83, v6, s[26:27] offset:768
    global_load_ushort v84, v6, s[26:27] offset:1024
    global_load_ushort v85, v6, s[26:27] offset:1280
    global_load_ushort v86, v6, s[26:27] offset:1536
    global_load_ushort v87, v6, s[26:27] offset:1792
    v_add_u32 v6, 4096, v6
    global_load_ushort v88, v6, s[26:27] offset:0
    global_load_ushort v89, v6, s[26:27] offset:256
    global_load_ushort v90, v6, s[26:27] offset:512
    global_load_ushort v91, v6, s[26:27] offset:768
    global_load_ushort v92, v6, s[26:27] offset:1024
    global_load_ushort v93, v6, s[26:27] offset:1280
    global_load_ushort v94, v6, s[26:27] offset:1536
    global_load_ushort v95, v6, s[26:27] offset:1792
    v_add_u32 v6, 4096, v6
    global_load_ushort v96, v6, s[26:27] offset:0
    global_load_ushort v97, v6, s[26:27] offset:256
    global_load_ushort v98, v6, s[26:27] offset:512
    global_load_ushort v99, v6, s[26:27] offset:768
    global_load_ushort v100, v6, s[26:27] offset:1024
    global_load_ushort v101, v6, s[26:27] offset:1280
    global_load_ushort v102, v6, s[26:27] offset:1536
    global_load_ushort v103, v6, s[26:27] offset:1792
    v_add_u32 v6, 4096, v6
    global_load_ushort v104, v6, s[26:27] offset:0
    global_load_ushort v105, v6, s[26:27] offset:256
    global_load_ushort v106, v6, s[26:27] offset:512
    global_load_ushort v107, v6, s[26:27] offset:768
    global_load_ushort v108, v6, s[26:27] offset:1024
    global_load_ushort v109, v6, s[26:27] offset:1280
    global_load_ushort v110, v6, s[26:27] offset:1536
    global_load_ushort v111, v6, s[26:27] offset:1792
    v_add_u32 v6, 4096, v6
    s_waitcnt vmcnt(0)
    v_lshl_or_b32 v16, v49, 16, v48
    v_lshl_or_b32 v17, v51, 16, v50
    v_lshl_or_b32 v18, v53, 16, v52
    v_lshl_or_b32 v19, v55, 16, v54
    v_lshl_or_b32 v20, v57, 16, v56
    v_lshl_or_b32 v21, v59, 16, v58
    v_lshl_or_b32 v22, v61, 16, v60
    v_lshl_or_b32 v23, v63, 16, v62
    v_lshl_or_b32 v24, v65, 16, v64
    v_lshl_or_b32 v25, v67, 16, v66
    v_lshl_or_b32 v26, v69, 16, v68
    v_lshl_or_b32 v27, v71, 16, v70
    v_lshl_or_b32 v28, v73, 16, v72
    v_lshl_or_b32 v29, v75, 16, v74
    v_lshl_or_b32 v30, v77, 16, v76
    v_lshl_or_b32 v31, v79, 16, v78
    v_lshl_or_b32 v32, v81, 16, v80
    v_lshl_or_b32 v33, v83, 16, v82
    v_lshl_or_b32 v34, v85, 16, v84
    v_lshl_or_b32 v35, v87, 16, v86
    v_lshl_or_b32 v36, v89, 16, v88
    v_lshl_or_b32 v37, v91, 16, v90
    v_lshl_or_b32 v38, v93, 16, v92
    v_lshl_or_b32 v39, v95, 16, v94
    v_lshl_or_b32 v40, v97, 16, v96
    v_lshl_or_b32 v41, v99, 16, v98
    v_lshl_or_b32 v42, v101, 16, v100
    v_lshl_or_b32 v43, v103, 16, v102
    v_lshl_or_b32 v44, v105, 16, v104
    v_lshl_or_b32 v45, v107, 16, v106
    v_lshl_or_b32 v46, v109, 16, v108
    v_lshl_or_b32 v47, v111, 16, v110
    v_add_u32 v8, s3, v1
    v_min_u32 v10, 9999, v8
    v_lshlrev_b32 v10, 8, v10
    v_lshl_add_u32 v10, v5, 1, v10
    global_load_dwordx4 v[48:51], v10, s[16:17] offset:0
    global_load_dwordx4 v[52:55], v10, s[16:17] offset:32
    global_load_dwordx4 v[56:59], v10, s[16:17] offset:64
    global_load_dwordx4 v[60:63], v10, s[16:17] offset:96
    global_load_dwordx4 v[64:67], v10, s[16:17] offset:128
    global_load_dwordx4 v[68:71], v10, s[16:17] offset:160
    global_load_dwordx4 v[72:75], v10, s[16:17] offset:192
    global_load_dwordx4 v[76:79], v10, s[16:17] offset:224
    v_add_u32 v9, s3, v1
    v_add_u32 v9, 32, v9
    v_min_u32 v10, 9999, v9
    v_lshlrev_b32 v10, 8, v10
    v_lshl_add_u32 v10, v5, 1, v10
    global_load_dwordx4 v[80:83], v10, s[16:17] offset:0
    global_load_dwordx4 v[84:87], v10, s[16:17] offset:32
    global_load_dwordx4 v[88:91], v10, s[16:17] offset:64
    global_load_dwordx4 v[92:95], v10, s[16:17] offset:96
    global_load_dwordx4 v[96:99], v10, s[16:17] offset:128
    global_load_dwordx4 v[100:103], v10, s[16:17] offset:160
    global_load_dwordx4 v[104:107], v10, s[16:17] offset:192
    global_load_dwordx4 v[108:111], v10, s[16:17] offset:224
    s_waitcnt vmcnt(0)
    v_mfma_f32_32x32x16_bf16 v[112:127], v[16:19], v[48:51], 0
    v_mfma_f32_32x32x16_bf16 v[112:127], v[20:23], v[52:55], v[112:127]
    v_mfma_f32_32x32x16_bf16 v[112:127], v[24:27], v[56:59], v[112:127]
    v_mfma_f32_32x32x16_bf16 v[112:127], v[28:31], v[60:63], v[112:127]
    v_mfma_f32_32x32x16_bf16 v[112:127], v[32:35], v[64:67], v[112:127]
    v_mfma_f32_32x32x16_bf16 v[112:127], v[36:39], v[68:71], v[112:127]
    v_mfma_f32_32x32x16_bf16 v[112:127], v[40:43], v[72:75], v[112:127]
    v_mfma_f32_32x32x16_bf16 v[112:127], v[44:47], v[76:79], v[112:127]
    v_mfma_f32_32x32x16_bf16 v[128:143], v[16:19], v[80:83], 0
    v_mfma_f32_32x32x16_bf16 v[128:143], v[20:23], v[84:87], v[128:143]
    v_mfma_f32_32x32x16_bf16 v[128:143], v[24:27], v[88:91], v[128:143]
    v_mfma_f32_32x32x16_bf16 v[128:143], v[28:31], v[92:95], v[128:143]
    v_mfma_f32_32x32x16_bf16 v[128:143], v[32:35], v[96:99], v[128:143]
    v_mfma_f32_32x32x16_bf16 v[128:143], v[36:39], v[100:103], v[128:143]
    v_mfma_f32_32x32x16_bf16 v[128:143], v[40:43], v[104:107], v[128:143]
    v_mfma_f32_32x32x16_bf16 v[128:143], v[44:47], v[108:111], v[128:143]
    s_nop 15
    v_lshl_add_u32 v11, v3, 5, 0
    v_lshl_add_u32 v11, v2, 2, v11
    v_lshlrev_b32 v11, 1, v11
    v_lshl_add_u32 v12, v8, 8, v11
    s_movk_i32 s4, 10000
    v_cmp_gt_u32 vcc, s4, v8
    s_and_saveexec_b64 s[6:7], vcc
    v_cvt_pk_bf16_f32 v112, v112, v113
    v_cvt_pk_bf16_f32 v113, v114, v115
    global_store_dwordx2 v12, v[112:113], s[32:33] offset:0
    v_cvt_pk_bf16_f32 v116, v116, v117
    v_cvt_pk_bf16_f32 v117, v118, v119
    global_store_dwordx2 v12, v[116:117], s[32:33] offset:16
    v_cvt_pk_bf16_f32 v120, v120, v121
    v_cvt_pk_bf16_f32 v121, v122, v123
    global_store_dwordx2 v12, v[120:121], s[32:33] offset:32
    v_cvt_pk_bf16_f32 v124, v124, v125
    v_cvt_pk_bf16_f32 v125, v126, v127
    global_store_dwordx2 v12, v[124:125], s[32:33] offset:48
    s_mov_b64 exec, s[6:7]
    v_lshl_add_u32 v12, v9, 8, v11
    s_movk_i32 s4, 10000
    v_cmp_gt_u32 vcc, s4, v9
    s_and_saveexec_b64 s[6:7], vcc
    v_cvt_pk_bf16_f32 v128, v128, v129
    v_cvt_pk_bf16_f32 v129, v130, v131
    global_store_dwordx2 v12, v[128:129], s[32:33] offset:0
    v_cvt_pk_bf16_f32 v132, v132, v133
    v_cvt_pk_bf16_f32 v133, v134, v135
    global_store_dwordx2 v12, v[132:133], s[32:33] offset:16
    v_cvt_pk_bf16_f32 v136, v136, v137
    v_cvt_pk_bf16_f32 v137, v138, v139
    global_store_dwordx2 v12, v[136:137], s[32:33] offset:32
    v_cvt_pk_bf16_f32 v140, v140, v141
    v_cvt_pk_bf16_f32 v141, v142, v143
    global_store_dwordx2 v12, v[140:141], s[32:33] offset:48
    s_mov_b64 exec, s[6:7]
    s_branch K1_end
K1_T:
    s_cmp_ge_u32 s2, 494
    s_cbranch_scc1 K1_end
    s_sub_u32 s3, s2, 470
    s_lshl_b32 s3, s3, 8
    v_add_u32 v1, s3, v0
    s_mov_b64 s[8:9], s[26:27]
    s_movk_i32 s10, 8
    s_mov_b32 s11, 2621440
    s_cmp_lt_u32 s2, 478
    s_cbranch_scc1 T_go
    v_subrev_u32 v1, 2048, v1
    s_mov_b64 s[8:9], s[30:31]
    s_movk_i32 s10, 9
    s_mov_b32 s11, 2654208
T_go:
    v_and_b32 v2, 127, v1
    v_lshrrev_b32 v3, 7, v1
    v_lshlrev_b32 v4, 11, v3
    v_lshl_add_u32 v4, v2, 1, v4
    global_load_ushort v16, v4, s[8:9] offset:0
    global_load_ushort v17, v4, s[8:9] offset:256
    global_load_ushort v18, v4, s[8:9] offset:512
    global_load_ushort v19, v4, s[8:9] offset:768
    global_load_ushort v20, v4, s[8:9] offset:1024
    global_load_ushort v21, v4, s[8:9] offset:1280
    global_load_ushort v22, v4, s[8:9] offset:1536
    global_load_ushort v23, v4, s[8:9] offset:1792
    v_lshlrev_b32 v5, s10, v2
    v_lshl_add_u32 v5, v3, 4, v5
    v_add_u32 v5, s11, v5
    s_waitcnt vmcnt(0)
    v_lshl_or_b32 v8, v17, 16, v16
    v_lshl_or_b32 v9, v19, 16, v18
    v_lshl_or_b32 v10, v21, 16, v20
    v_lshl_or_b32 v11, v23, 16, v22
    global_store_dwordx4 v5, v[8:11], s[32:33]
K1_end:
    s_endpgm
.globl k2_kernel
.p2align 8
.type k2_kernel,@function
k2_kernel:
    s_cmp_ge_u32 s2, 250
    s_cbranch_scc1 K2_end
    s_load_dwordx16 s[16:31], s[0:1], 0
    s_load_dwordx2 s[32:33], s[0:1], 80
    s_load_dwordx2 s[34:35], s[0:1], 64
    s_waitcnt lgkmcnt(0)
    s_mul_i32 s36, s2, 40
    s_mov_b32 s60, 0
    v_lshrrev_b32 v1, 6, v0
    s_nop 0
    v_readfirstlane_b32 s37, v1
    v_and_b32 v2, 63, v0
    v_and_b32 v3, 15, v0
    v_bfe_u32 v4, v0, 4, 2
    v_mov_b32 v5, 0
    v_lshlrev_b32 v6, 2, v0
    ds_write_b32 v6, v5 offset:24576
    ds_write_b32 v6, v5 offset:28672
    ds_write_b32 v6, v5 offset:32768
    ds_write_b32 v6, v5 offset:36864
    ds_write_b32 v6, v5 offset:40960
    v_cmp_gt_u32 vcc, 336, v0
    s_and_saveexec_b64 s[6:7], vcc
    ds_write_b32 v6, v5 offset:45056
    s_mov_b64 exec, s[6:7]
    v_lshlrev_b32 v7, 4, v3
    v_lshlrev_b32 v8, 2, v0
    s_mul_i32 s3, s2, 1280
    s_add_u32 s3, s3, 2752512
    v_add_u32 v8, s3, v8
    v_cmp_gt_u32 vcc, 313, v0
    s_and_saveexec_b64 s[40:41], vcc
    s_mov_b64 s[42:43], exec
    global_load_dword v10, v8, s[32:33]
    global_load_dword v11, v8, s[32:33] offset:1280
    s_mov_b64 exec, s[40:41]
    s_waitcnt vmcnt(0)
    v_mul_u32_u24 v6, 517, v0
    v_mov_b32 v1, v10
    v_mov_b32 v5, v11
PASS:
    s_waitcnt lgkmcnt(0)
    s_barrier
    s_cmp_lt_u32 s37, 8
    s_cbranch_scc1 G1_skip
    s_cmp_lg_u32 s60, 0
    s_cbranch_scc1 G1_skip
    s_sub_u32 s3, s37, 8
    s_lshl_b32 s3, s3, 4
    v_add_u32 v12, s3, v3
    v_lshlrev_b32 v12, 8, v12
    v_lshl_add_u32 v12, v4, 4, v12
    v_add_u32 v12, 2621440, v12
    global_load_dwordx4 v[16:19], v12, s[32:33] offset:0
    global_load_dwordx4 v[20:23], v12, s[32:33] offset:64
    global_load_dwordx4 v[24:27], v12, s[32:33] offset:128
    global_load_dwordx4 v[28:31], v12, s[32:33] offset:192
    v_add3_u32 v13, s36, v3, 0
    v_min_u32 v13, 9999, v13
    v_lshlrev_b32 v13, 8, v13
    v_lshl_add_u32 v13, v4, 4, v13
    global_load_dwordx4 v[32:35], v13, s[16:17] offset:0
    global_load_dwordx4 v[36:39], v13, s[16:17] offset:64
    global_load_dwordx4 v[40:43], v13, s[16:17] offset:128
    global_load_dwordx4 v[44:47], v13, s[16:17] offset:192
    v_add3_u32 v13, s36, v3, 16
    v_min_u32 v13, 9999, v13
    v_lshlrev_b32 v13, 8, v13
    v_lshl_add_u32 v13, v4, 4, v13
    global_load_dwordx4 v[48:51], v13, s[16:17] offset:0
    global_load_dwordx4 v[52:55], v13, s[16:17] offset:64
    global_load_dwordx4 v[56:59], v13, s[16:17] offset:128
    global_load_dwordx4 v[60:63], v13, s[16:17] offset:192
    v_add3_u32 v13, s36, v3, 32
    v_min_u32 v13, 9999, v13
    v_lshlrev_b32 v13, 8, v13
    v_lshl_add_u32 v13, v4, 4, v13
    global_load_dwordx4 v[64:67], v13, s[16:17] offset:0
    global_load_dwordx4 v[68:71], v13, s[16:17] offset:64
    global_load_dwordx4 v[72:75], v13, s[16:17] offset:128
    global_load_dwordx4 v[76:79], v13, s[16:17] offset:192
    s_waitcnt vmcnt(0)
    v_mfma_f32_16x16x32_bf16 v[80:83], v[16:19], v[32:35], 0
    v_mfma_f32_16x16x32_bf16 v[80:83], v[20:23], v[36:39], v[80:83]
    v_mfma_f32_16x16x32_bf16 v[80:83], v[24:27], v[40:43], v[80:83]
    v_mfma_f32_16x16x32_bf16 v[80:83], v[28:31], v[44:47], v[80:83]
    v_mfma_f32_16x16x32_bf16 v[84:87], v[16:19], v[48:51], 0
    v_mfma_f32_16x16x32_bf16 v[84:87], v[20:23], v[52:55], v[84:87]
    v_mfma_f32_16x16x32_bf16 v[84:87], v[24:27], v[56:59], v[84:87]
    v_mfma_f32_16x16x32_bf16 v[84:87], v[28:31], v[60:63], v[84:87]
    v_mfma_f32_16x16x32_bf16 v[88:91], v[16:19], v[64:67], 0
    v_mfma_f32_16x16x32_bf16 v[88:91], v[20:23], v[68:71], v[88:91]
    v_mfma_f32_16x16x32_bf16 v[88:91], v[24:27], v[72:75], v[88:91]
    v_mfma_f32_16x16x32_bf16 v[88:91], v[28:31], v[76:79], v[88:91]
    s_lshl_b32 s4, s3, 2
    s_nop 7
    v_add_u32 v14, 0, v3
    v_lshlrev_b32 v14, 9, v14
    v_lshl_add_u32 v14, v4, 4, v14
    v_add_u32 v14, s4, v14
    ds_write_b128 v14, v[80:83]
    v_add_u32 v14, 16, v3
    v_lshlrev_b32 v14, 9, v14
    v_lshl_add_u32 v14, v4, 4, v14
    v_add_u32 v14, s4, v14
    ds_write_b128 v14, v[84:87]
    v_add_u32 v14, 32, v3
    v_lshlrev_b32 v14, 9, v14
    v_lshl_add_u32 v14, v4, 4, v14
    v_add_u32 v14, s4, v14
    ds_write_b128 v14, v[88:91]
G1_skip:
    s_cmp_ge_u32 s37, 5
    s_cbranch_scc1 F_skip
    s_mov_b64 exec, s[42:43]
    v_sub_u32 v20, v5, v1
    v_min_u32 v20, 10, v20
    v_add_u32 v21, v6, v1
    v_lshlrev_b32 v21, 5, v21
    v_add_u32 v21, 3145728, v21
    v_cmp_lt_u32 vcc, 0, v20
    s_and_b64 exec, s[42:43], vcc
    global_load_dwordx4 v[32:35], v21, s[32:33] offset:0
    global_load_dwordx2 v[36:37], v21, s[32:33] offset:16
    v_cmp_lt_u32 vcc, 1, v20
    s_and_b64 exec, s[42:43], vcc
    global_load_dwordx4 v[38:41], v21, s[32:33] offset:32
    global_load_dwordx2 v[42:43], v21, s[32:33] offset:48
    v_cmp_lt_u32 vcc, 2, v20
    s_and_b64 exec, s[42:43], vcc
    global_load_dwordx4 v[44:47], v21, s[32:33] offset:64
    global_load_dwordx2 v[48:49], v21, s[32:33] offset:80
    v_cmp_lt_u32 vcc, 3, v20
    s_and_b64 exec, s[42:43], vcc
    global_load_dwordx4 v[50:53], v21, s[32:33] offset:96
    global_load_dwordx2 v[54:55], v21, s[32:33] offset:112
    v_cmp_lt_u32 vcc, 4, v20
    s_and_b64 exec, s[42:43], vcc
    global_load_dwordx4 v[56:59], v21, s[32:33] offset:128
    global_load_dwordx2 v[60:61], v21, s[32:33] offset:144
    v_cmp_lt_u32 vcc, 5, v20
    s_and_b64 exec, s[42:43], vcc
    global_load_dwordx4 v[62:65], v21, s[32:33] offset:160
    global_load_dwordx2 v[66:67], v21, s[32:33] offset:176
    v_cmp_lt_u32 vcc, 6, v20
    s_and_b64 exec, s[42:43], vcc
    global_load_dwordx4 v[68:71], v21, s[32:33] offset:192
    global_load_dwordx2 v[72:73], v21, s[32:33] offset:208
    v_cmp_lt_u32 vcc, 7, v20
    s_and_b64 exec, s[42:43], vcc
    global_load_dwordx4 v[74:77], v21, s[32:33] offset:224
    global_load_dwordx2 v[78:79], v21, s[32:33] offset:240
    v_cmp_lt_u32 vcc, 8, v20
    s_and_b64 exec, s[42:43], vcc
    global_load_dwordx4 v[80:83], v21, s[32:33] offset:256
    global_load_dwordx2 v[84:85], v21, s[32:33] offset:272
    v_cmp_lt_u32 vcc, 9, v20
    s_and_b64 exec, s[42:43], vcc
    global_load_dwordx4 v[86:89], v21, s[32:33] offset:288
    global_load_dwordx2 v[90:91], v21, s[32:33] offset:304
    s_mov_b64 exec, s[42:43]
    v_add_u32 v1, v1, v20
    v_cmp_lt_u32 vcc, v1, v5
    s_and_b64 exec, s[42:43], vcc
    v_mov_b32 v22, 1
    v_mov_b32 v23, 45824
    ds_write_b32 v23, v22 offset:4
    s_mov_b64 exec, s[42:43]
    v_mov_b32 v22, 1
    s_waitcnt vmcnt(0)
    v_cmp_lt_u32 vcc, 0, v20
    s_and_b64 exec, s[42:43], vcc
    v_lshrrev_b32 v23, 16, v32
    v_lshlrev_b32 v23, 2, v23
    ds_add_rtn_u32 v8, v23, v22 offset:45840
    v_cmp_lt_u32 vcc, 1, v20
    s_and_b64 exec, s[42:43], vcc
    v_lshrrev_b32 v23, 16, v38
    v_lshlrev_b32 v23, 2, v23
    ds_add_rtn_u32 v9, v23, v22 offset:45840
    v_cmp_lt_u32 vcc, 2, v20
    s_and_b64 exec, s[42:43], vcc
    v_lshrrev_b32 v23, 16, v44
    v_lshlrev_b32 v23, 2, v23
    ds_add_rtn_u32 v10, v23, v22 offset:45840
    v_cmp_lt_u32 vcc, 3, v20
    s_and_b64 exec, s[42:43], vcc
    v_lshrrev_b32 v23, 16, v50
    v_lshlrev_b32 v23, 2, v23
    ds_add_rtn_u32 v11, v23, v22 offset:45840
    v_cmp_lt_u32 vcc, 4, v20
    s_and_b64 exec, s[42:43], vcc
    v_lshrrev_b32 v23, 16, v56
    v_lshlrev_b32 v23, 2, v23
    ds_add_rtn_u32 v12, v23, v22 offset:45840
    v_cmp_lt_u32 vcc, 5, v20
    s_and_b64 exec, s[42:43], vcc
    v_lshrrev_b32 v23, 16, v62
    v_lshlrev_b32 v23, 2, v23
    ds_add_rtn_u32 v13, v23, v22 offset:45840
    v_cmp_lt_u32 vcc, 6, v20
    s_and_b64 exec, s[42:43], vcc
    v_lshrrev_b32 v23, 16, v68
    v_lshlrev_b32 v23, 2, v23
    ds_add_rtn_u32 v14, v23, v22 offset:45840
    v_cmp_lt_u32 vcc, 7, v20
    s_and_b64 exec, s[42:43], vcc
    v_lshrrev_b32 v23, 16, v74
    v_lshlrev_b32 v23, 2, v23
    ds_add_rtn_u32 v15, v23, v22 offset:45840
    v_cmp_lt_u32 vcc, 8, v20
    s_and_b64 exec, s[42:43], vcc
    v_lshrrev_b32 v23, 16, v80
    v_lshlrev_b32 v23, 2, v23
    ds_add_rtn_u32 v16, v23, v22 offset:45840
    v_cmp_lt_u32 vcc, 9, v20
    s_and_b64 exec, s[42:43], vcc
    v_lshrrev_b32 v23, 16, v86
    v_lshlrev_b32 v23, 2, v23
    ds_add_rtn_u32 v17, v23, v22 offset:45840
    s_mov_b64 exec, -1
F_skip:
    s_waitcnt lgkmcnt(0)
    s_barrier
    s_cmp_lg_u32 s37, 0
    s_cbranch_scc1 F2
    v_lshlrev_b32 v23, 2, v2
    ds_read_b32 v24, v23 offset:45840
    s_waitcnt lgkmcnt(0)
    v_mov_b32 v25, v24
    s_nop 1
    v_add_u32_dpp v25, v25, v25 row_shr:1 row_mask:0xf bank_mask:0xf bound_ctrl:0
    s_nop 1
    v_add_u32_dpp v25, v25, v25 row_shr:2 row_mask:0xf bank_mask:0xf bound_ctrl:0
    s_nop 1
    v_add_u32_dpp v25, v25, v25 row_shr:4 row_mask:0xf bank_mask:0xf bound_ctrl:0
    s_nop 1
    v_add_u32_dpp v25, v25, v25 row_shr:8 row_mask:0xf bank_mask:0xf bound_ctrl:0
    s_nop 1
    v_add_u32_dpp v25, v25, v25 row_bcast:15 row_mask:0xa bank_mask:0xf
    s_nop 1
    v_add_u32_dpp v25, v25, v25 row_bcast:31 row_mask:0xc bank_mask:0xf
    v_sub_u32 v25, v25, v24
    ds_write_b32 v23, v25 offset:46096
    v_mov_b32 v24, 0
    ds_write_b32 v23, v24 offset:45840
F2:
    s_waitcnt lgkmcnt(0)
    s_barrier
    s_cmp_ge_u32 s37, 5
    s_cbranch_scc1 F3
    v_cmp_lt_u32 vcc, 0, v20
    s_and_b64 exec, s[42:43], vcc
    v_lshrrev_b32 v23, 16, v32
    v_lshlrev_b32 v23, 2, v23
    ds_read_b32 v24, v23 offset:46096
    s_waitcnt lgkmcnt(0)
    v_add_u32 v24, v24, v8
    v_mul_u32_u24 v24, 24, v24
    ds_write_b64 v24, v[32:33] offset:46400
    ds_write_b64 v24, v[34:35] offset:46408
    ds_write_b64 v24, v[36:37] offset:46416
    v_cmp_lt_u32 vcc, 1, v20
    s_and_b64 exec, s[42:43], vcc
    v_lshrrev_b32 v23, 16, v38
    v_lshlrev_b32 v23, 2, v23
    ds_read_b32 v24, v23 offset:46096
    s_waitcnt lgkmcnt(0)
    v_add_u32 v24, v24, v9
    v_mul_u32_u24 v24, 24, v24
    ds_write_b64 v24, v[38:39] offset:46400
    ds_write_b64 v24, v[40:41] offset:46408
    ds_write_b64 v24, v[42:43] offset:46416
    v_cmp_lt_u32 vcc, 2, v20
    s_and_b64 exec, s[42:43], vcc
    v_lshrrev_b32 v23, 16, v44
    v_lshlrev_b32 v23, 2, v23
    ds_read_b32 v24, v23 offset:46096
    s_waitcnt lgkmcnt(0)
    v_add_u32 v24, v24, v10
    v_mul_u32_u24 v24, 24, v24
    ds_write_b64 v24, v[44:45] offset:46400
    ds_write_b64 v24, v[46:47] offset:46408
    ds_write_b64 v24, v[48:49] offset:46416
    v_cmp_lt_u32 vcc, 3, v20
    s_and_b64 exec, s[42:43], vcc
    v_lshrrev_b32 v23, 16, v50
    v_lshlrev_b32 v23, 2, v23
    ds_read_b32 v24, v23 offset:46096
    s_waitcnt lgkmcnt(0)
    v_add_u32 v24, v24, v11
    v_mul_u32_u24 v24, 24, v24
    ds_write_b64 v24, v[50:51] offset:46400
    ds_write_b64 v24, v[52:53] offset:46408
    ds_write_b64 v24, v[54:55] offset:46416
    v_cmp_lt_u32 vcc, 4, v20
    s_and_b64 exec, s[42:43], vcc
    v_lshrrev_b32 v23, 16, v56
    v_lshlrev_b32 v23, 2, v23
    ds_read_b32 v24, v23 offset:46096
    s_waitcnt lgkmcnt(0)
    v_add_u32 v24, v24, v12
    v_mul_u32_u24 v24, 24, v24
    ds_write_b64 v24, v[56:57] offset:46400
    ds_write_b64 v24, v[58:59] offset:46408
    ds_write_b64 v24, v[60:61] offset:46416
    v_cmp_lt_u32 vcc, 5, v20
    s_and_b64 exec, s[42:43], vcc
    v_lshrrev_b32 v23, 16, v62
    v_lshlrev_b32 v23, 2, v23
    ds_read_b32 v24, v23 offset:46096
    s_waitcnt lgkmcnt(0)
    v_add_u32 v24, v24, v13
    v_mul_u32_u24 v24, 24, v24
    ds_write_b64 v24, v[62:63] offset:46400
    ds_write_b64 v24, v[64:65] offset:46408
    ds_write_b64 v24, v[66:67] offset:46416
    v_cmp_lt_u32 vcc, 6, v20
    s_and_b64 exec, s[42:43], vcc
    v_lshrrev_b32 v23, 16, v68
    v_lshlrev_b32 v23, 2, v23
    ds_read_b32 v24, v23 offset:46096
    s_waitcnt lgkmcnt(0)
    v_add_u32 v24, v24, v14
    v_mul_u32_u24 v24, 24, v24
    ds_write_b64 v24, v[68:69] offset:46400
    ds_write_b64 v24, v[70:71] offset:46408
    ds_write_b64 v24, v[72:73] offset:46416
    v_cmp_lt_u32 vcc, 7, v20
    s_and_b64 exec, s[42:43], vcc
    v_lshrrev_b32 v23, 16, v74
    v_lshlrev_b32 v23, 2, v23
    ds_read_b32 v24, v23 offset:46096
    s_waitcnt lgkmcnt(0)
    v_add_u32 v24, v24, v15
    v_mul_u32_u24 v24, 24, v24
    ds_write_b64 v24, v[74:75] offset:46400
    ds_write_b64 v24, v[76:77] offset:46408
    ds_write_b64 v24, v[78:79] offset:46416
    v_cmp_lt_u32 vcc, 8, v20
    s_and_b64 exec, s[42:43], vcc
    v_lshrrev_b32 v23, 16, v80
    v_lshlrev_b32 v23, 2, v23
    ds_read_b32 v24, v23 offset:46096
    s_waitcnt lgkmcnt(0)
    v_add_u32 v24, v24, v16
    v_mul_u32_u24 v24, 24, v24
    ds_write_b64 v24, v[80:81] offset:46400
    ds_write_b64 v24, v[82:83] offset:46408
    ds_write_b64 v24, v[84:85] offset:46416
    v_cmp_lt_u32 vcc, 9, v20
    s_and_b64 exec, s[42:43], vcc
    v_lshrrev_b32 v23, 16, v86
    v_lshlrev_b32 v23, 2, v23
    ds_read_b32 v24, v23 offset:46096
    s_waitcnt lgkmcnt(0)
    v_add_u32 v24, v24, v17
    v_mul_u32_u24 v24, 24, v24
    ds_write_b64 v24, v[86:87] offset:46400
    ds_write_b64 v24, v[88:89] offset:46408
    ds_write_b64 v24, v[90:91] offset:46416
    s_mov_b64 exec, -1
F3:
    v_add_u32 v9, 65536, v7
    global_load_dwordx4 v[32:35], v9, s[26:27] offset:0
    global_load_dwordx4 v[36:39], v9, s[26:27] offset:256
    global_load_dwordx4 v[40:43], v9, s[26:27] offset:512
    global_load_dwordx4 v[44:47], v9, s[26:27] offset:768
    global_load_dwordx4 v[48:51], v9, s[26:27] offset:1024
    global_load_dwordx4 v[52:55], v7, s[28:29]
    s_waitcnt vmcnt(0)
    v_lshlrev_b32 v64, 16, v32
    v_and_b32 v65, 0xffff0000, v32
    v_lshlrev_b32 v66, 16, v33
    v_and_b32 v67, 0xffff0000, v33
    v_lshlrev_b32 v68, 16, v34
    v_and_b32 v69, 0xffff0000, v34
    v_lshlrev_b32 v70, 16, v35
    v_and_b32 v71, 0xffff0000, v35
    v_lshlrev_b32 v72, 16, v36
    v_and_b32 v73, 0xffff0000, v36
    v_lshlrev_b32 v74, 16, v37
    v_and_b32 v75, 0xffff0000, v37
    v_lshlrev_b32 v76, 16, v38
    v_and_b32 v77, 0xffff0000, v38
    v_lshlrev_b32 v78, 16, v39
    v_and_b32 v79, 0xffff0000, v39
    v_lshlrev_b32 v80, 16, v40
    v_and_b32 v81, 0xffff0000, v40
    v_lshlrev_b32 v82, 16, v41
    v_and_b32 v83, 0xffff0000, v41
    v_lshlrev_b32 v84, 16, v42
    v_and_b32 v85, 0xffff0000, v42
    v_lshlrev_b32 v86, 16, v43
    v_and_b32 v87, 0xffff0000, v43
    v_lshlrev_b32 v88, 16, v44
    v_and_b32 v89, 0xffff0000, v44
    v_lshlrev_b32 v90, 16, v45
    v_and_b32 v91, 0xffff0000, v45
    v_lshlrev_b32 v92, 16, v46
    v_and_b32 v93, 0xffff0000, v46
    v_lshlrev_b32 v94, 16, v47
    v_and_b32 v95, 0xffff0000, v47
    v_lshlrev_b32 v96, 16, v48
    v_and_b32 v97, 0xffff0000, v48
    v_lshlrev_b32 v98, 16, v49
    v_and_b32 v99, 0xffff0000, v49
    v_lshlrev_b32 v100, 16, v50
    v_and_b32 v101, 0xffff0000, v50
    v_lshlrev_b32 v102, 16, v51
    v_and_b32 v103, 0xffff0000, v51
    v_lshlrev_b32 v104, 16, v52
    v_and_b32 v105, 0xffff0000, v52
    v_lshlrev_b32 v106, 16, v53
    v_and_b32 v107, 0xffff0000, v53
    v_lshlrev_b32 v108, 16, v54
    v_and_b32 v109, 0xffff0000, v54
    v_lshlrev_b32 v110, 16, v55
    v_and_b32 v111, 0xffff0000, v55
    s_waitcnt lgkmcnt(0)
    s_barrier
    v_mov_b32 v14, 45824
    ds_read_b64 v[16:17], v14
    s_waitcnt lgkmcnt(0)
    s_nop 0
    v_readfirstlane_b32 s39, v17
    s_mov_b32 s44, 0xbfb8aa3b
    s_mov_b32 s45, 0xbfb8aa3b
NLOOP:
    s_mov_b64 exec, 1
    v_mov_b32 v14, 45824
    v_mov_b32 v15, 1
    ds_add_rtn_u32 v15, v14, v15
    s_waitcnt lgkmcnt(0)
    v_readfirstlane_b32 s48, v15
    s_mov_b64 exec, -1
    s_cmp_ge_u32 s48, 40
    s_cbranch_scc1 E_done
    s_lshl_b32 s3, s48, 2
    v_mov_b32 v14, s3
    ds_read_b64 v[16:17], v14 offset:46096
    s_lshl_b32 s3, s48, 9
    v_lshl_add_u32 v15, v7, 1, s3
    ds_read_b128 v[8:11], v15
    ds_read_b128 v[12:15], v15 offset:16
    v_mov_b32 v112, 0
    v_mov_b32 v113, 0
    v_mov_b32 v114, 0
    v_mov_b32 v115, 0
    v_mov_b32 v116, 0
    v_mov_b32 v117, 0
    v_mov_b32 v118, 0
    v_mov_b32 v119, 0
    v_mov_b32 v120, 0
    v_mov_b32 v121, 0
    v_mov_b32 v56, 0
    s_waitcnt lgkmcnt(0)
    v_readfirstlane_b32 s51, v16
    v_readfirstlane_b32 s50, v17
    s_cmp_ge_u32 s51, s50
    s_cbranch_scc1 N_end
    s_sub_u32 s46, s50, 1
ILOOP:
    v_add_u32 v16, s51, v4
    v_add_u32 v16, 0, v16
    v_cmp_gt_u32 s[52:53], s50, v16
    v_min_u32 v16, s46, v16
    v_mul_u32_u24 v16, 24, v16
    ds_read_b32 v24, v16 offset:46400
    v_add_u32 v17, s51, v4
    v_add_u32 v17, 4, v17
    v_cmp_gt_u32 s[54:55], s50, v17
    v_min_u32 v17, s46, v17
    v_mul_u32_u24 v17, 24, v17
    ds_read_b32 v25, v17 offset:46400
    s_waitcnt lgkmcnt(0)
    v_and_b32 v24, 0xffff, v24
    v_lshl_add_u32 v24, v24, 8, v7
    global_load_dwordx4 v[32:35], v24, s[32:33]
    v_and_b32 v25, 0xffff, v25
    v_lshl_add_u32 v25, v25, 8, v7
    global_load_dwordx4 v[36:39], v25, s[32:33]
    ds_read_b32 v57, v16 offset:46404
    ds_read_b64 v[58:59], v16 offset:46408
    ds_read_b64 v[60:61], v16 offset:46416
    s_waitcnt vmcnt(1)
    v_lshlrev_b32 v24, 16, v32
    v_and_b32 v25, 0xffff0000, v32
    v_lshlrev_b32 v26, 16, v33
    v_and_b32 v27, 0xffff0000, v33
    v_lshlrev_b32 v28, 16, v34
    v_and_b32 v29, 0xffff0000, v34
    v_lshlrev_b32 v30, 16, v35
    v_and_b32 v31, 0xffff0000, v35
    v_pk_add_f32 v[24:25], v[24:25], v[8:9]
    v_pk_add_f32 v[26:27], v[26:27], v[10:11]
    v_pk_add_f32 v[28:29], v[28:29], v[12:13]
    v_pk_add_f32 v[30:31], v[30:31], v[14:15]
    s_waitcnt lgkmcnt(0)
    v_lshlrev_b32 v122, 16, v58
    v_and_b32 v123, 0xffff0000, v58
    v_lshlrev_b32 v124, 16, v59
    v_and_b32 v125, 0xffff0000, v59
    v_pk_fma_f32 v[24:25], v[56:57], v[64:65], v[24:25] op_sel:[1,0,0] op_sel_hi:[1,1,1]
    v_pk_fma_f32 v[26:27], v[56:57], v[66:67], v[26:27] op_sel:[1,0,0] op_sel_hi:[1,1,1]
    v_pk_fma_f32 v[28:29], v[56:57], v[68:69], v[28:29] op_sel:[1,0,0] op_sel_hi:[1,1,1]
    v_pk_fma_f32 v[30:31], v[56:57], v[70:71], v[30:31] op_sel:[1,0,0] op_sel_hi:[1,1,1]
    v_pk_fma_f32 v[24:25], v[122:123], v[72:73], v[24:25] op_sel_hi:[0,1,1]
    v_pk_fma_f32 v[26:27], v[122:123], v[74:75], v[26:27] op_sel_hi:[0,1,1]
    v_pk_fma_f32 v[28:29], v[122:123], v[76:77], v[28:29] op_sel_hi:[0,1,1]
    v_pk_fma_f32 v[30:31], v[122:123], v[78:79], v[30:31] op_sel_hi:[0,1,1]
    v_pk_fma_f32 v[24:25], v[122:123], v[80:81], v[24:25] op_sel:[1,0,0] op_sel_hi:[1,1,1]
    v_pk_fma_f32 v[26:27], v[122:123], v[82:83], v[26:27] op_sel:[1,0,0] op_sel_hi:[1,1,1]
    v_pk_fma_f32 v[28:29], v[122:123], v[84:85], v[28:29] op_sel:[1,0,0] op_sel_hi:[1,1,1]
    v_pk_fma_f32 v[30:31], v[122:123], v[86:87], v[30:31] op_sel:[1,0,0] op_sel_hi:[1,1,1]
    v_pk_fma_f32 v[24:25], v[124:125], v[88:89], v[24:25] op_sel_hi:[0,1,1]
    v_pk_fma_f32 v[26:27], v[124:125], v[90:91], v[26:27] op_sel_hi:[0,1,1]
    v_pk_fma_f32 v[28:29], v[124:125], v[92:93], v[28:29] op_sel_hi:[0,1,1]
    v_pk_fma_f32 v[30:31], v[124:125], v[94:95], v[30:31] op_sel_hi:[0,1,1]
    v_pk_fma_f32 v[24:25], v[124:125], v[96:97], v[24:25] op_sel:[1,0,0] op_sel_hi:[1,1,1]
    v_pk_fma_f32 v[26:27], v[124:125], v[98:99], v[26:27] op_sel:[1,0,0] op_sel_hi:[1,1,1]
    v_pk_fma_f32 v[28:29], v[124:125], v[100:101], v[28:29] op_sel:[1,0,0] op_sel_hi:[1,1,1]
    v_pk_fma_f32 v[30:31], v[124:125], v[102:103], v[30:31] op_sel:[1,0,0] op_sel_hi:[1,1,1]
    v_pk_mul_f32 v[32:33], v[24:25], s[44:45]
    v_pk_mul_f32 v[34:35], v[26:27], s[44:45]
    v_pk_mul_f32 v[62:63], v[28:29], s[44:45]
    v_pk_mul_f32 v[126:127], v[30:31], s[44:45]
    v_exp_f32 v32, v32
    v_exp_f32 v33, v33
    v_exp_f32 v34, v34
    v_exp_f32 v35, v35
    v_exp_f32 v62, v62
    v_exp_f32 v63, v63
    v_exp_f32 v126, v126
    v_exp_f32 v127, v127
    s_nop 0
    v_pk_add_f32 v[32:33], v[32:33], 1.0 op_sel_hi:[1,0]
    v_pk_add_f32 v[34:35], v[34:35], 1.0 op_sel_hi:[1,0]
    v_pk_add_f32 v[62:63], v[62:63], 1.0 op_sel_hi:[1,0]
    v_pk_add_f32 v[126:127], v[126:127], 1.0 op_sel_hi:[1,0]
    v_rcp_f32 v32, v32
    v_rcp_f32 v33, v33
    v_rcp_f32 v34, v34
    v_rcp_f32 v35, v35
    v_rcp_f32 v62, v62
    v_rcp_f32 v63, v63
    v_rcp_f32 v126, v126
    v_rcp_f32 v127, v127
    s_nop 0
    v_pk_mul_f32 v[24:25], v[24:25], v[32:33]
    v_pk_mul_f32 v[26:27], v[26:27], v[34:35]
    v_pk_mul_f32 v[28:29], v[28:29], v[62:63]
    v_pk_mul_f32 v[30:31], v[30:31], v[126:127]
    v_pk_mul_f32 v[62:63], v[24:25], v[104:105]
    v_pk_fma_f32 v[62:63], v[26:27], v[106:107], v[62:63]
    v_pk_fma_f32 v[62:63], v[28:29], v[108:109], v[62:63]
    v_pk_fma_f32 v[62:63], v[30:31], v[110:111], v[62:63]
    v_add_f32 v62, v62, v63
    v_lshlrev_b32 v63, 16, v60
    v_and_b32 v126, 0xffff0000, v60
    v_lshlrev_b32 v127, 16, v61
    s_mov_b64 exec, s[52:53]
    v_pk_add_f32 v[112:113], v[112:113], v[24:25]
    v_pk_add_f32 v[114:115], v[114:115], v[26:27]
    v_pk_add_f32 v[116:117], v[116:117], v[28:29]
    v_pk_add_f32 v[118:119], v[118:119], v[30:31]
    v_fmac_f32 v120, v62, v63
    v_fmac_f32 v121, v62, v126
    v_fmac_f32 v56, v62, v127
    s_mov_b64 exec, -1
    s_add_u32 s3, s51, 4
    s_cmp_ge_u32 s3, s50
    s_cbranch_scc1 N_end
    ds_read_b32 v57, v17 offset:46404
    ds_read_b64 v[58:59], v17 offset:46408
    ds_read_b64 v[60:61], v17 offset:46416
    s_waitcnt vmcnt(0)
    v_lshlrev_b32 v24, 16, v36
    v_and_b32 v25, 0xffff0000, v36
    v_lshlrev_b32 v26, 16, v37
    v_and_b32 v27, 0xffff0000, v37
    v_lshlrev_b32 v28, 16, v38
    v_and_b32 v29, 0xffff0000, v38
    v_lshlrev_b32 v30, 16, v39
    v_and_b32 v31, 0xffff0000, v39
    v_pk_add_f32 v[24:25], v[24:25], v[8:9]
    v_pk_add_f32 v[26:27], v[26:27], v[10:11]
    v_pk_add_f32 v[28:29], v[28:29], v[12:13]
    v_pk_add_f32 v[30:31], v[30:31], v[14:15]
    s_waitcnt lgkmcnt(0)
    v_lshlrev_b32 v122, 16, v58
    v_and_b32 v123, 0xffff0000, v58
    v_lshlrev_b32 v124, 16, v59
    v_and_b32 v125, 0xffff0000, v59
    v_pk_fma_f32 v[24:25], v[56:57], v[64:65], v[24:25] op_sel:[1,0,0] op_sel_hi:[1,1,1]
    v_pk_fma_f32 v[26:27], v[56:57], v[66:67], v[26:27] op_sel:[1,0,0] op_sel_hi:[1,1,1]
    v_pk_fma_f32 v[28:29], v[56:57], v[68:69], v[28:29] op_sel:[1,0,0] op_sel_hi:[1,1,1]
    v_pk_fma_f32 v[30:31], v[56:57], v[70:71], v[30:31] op_sel:[1,0,0] op_sel_hi:[1,1,1]
    v_pk_fma_f32 v[24:25], v[122:123], v[72:73], v[24:25] op_sel_hi:[0,1,1]
    v_pk_fma_f32 v[26:27], v[122:123], v[74:75], v[26:27] op_sel_hi:[0,1,1]
    v_pk_fma_f32 v[28:29], v[122:123], v[76:77], v[28:29] op_sel_hi:[0,1,1]
    v_pk_fma_f32 v[30:31], v[122:123], v[78:79], v[30:31] op_sel_hi:[0,1,1]
    v_pk_fma_f32 v[24:25], v[122:123], v[80:81], v[24:25] op_sel:[1,0,0] op_sel_hi:[1,1,1]
    v_pk_fma_f32 v[26:27], v[122:123], v[82:83], v[26:27] op_sel:[1,0,0] op_sel_hi:[1,1,1]
    v_pk_fma_f32 v[28:29], v[122:123], v[84:85], v[28:29] op_sel:[1,0,0] op_sel_hi:[1,1,1]
    v_pk_fma_f32 v[30:31], v[122:123], v[86:87], v[30:31] op_sel:[1,0,0] op_sel_hi:[1,1,1]
    v_pk_fma_f32 v[24:25], v[124:125], v[88:89], v[24:25] op_sel_hi:[0,1,1]
    v_pk_fma_f32 v[26:27], v[124:125], v[90:91], v[26:27] op_sel_hi:[0,1,1]
    v_pk_fma_f32 v[28:29], v[124:125], v[92:93], v[28:29] op_sel_hi:[0,1,1]
    v_pk_fma_f32 v[30:31], v[124:125], v[94:95], v[30:31] op_sel_hi:[0,1,1]
    v_pk_fma_f32 v[24:25], v[124:125], v[96:97], v[24:25] op_sel:[1,0,0] op_sel_hi:[1,1,1]
    v_pk_fma_f32 v[26:27], v[124:125], v[98:99], v[26:27] op_sel:[1,0,0] op_sel_hi:[1,1,1]
    v_pk_fma_f32 v[28:29], v[124:125], v[100:101], v[28:29] op_sel:[1,0,0] op_sel_hi:[1,1,1]
    v_pk_fma_f32 v[30:31], v[124:125], v[102:103], v[30:31] op_sel:[1,0,0] op_sel_hi:[1,1,1]
    v_pk_mul_f32 v[36:37], v[24:25], s[44:45]
    v_pk_mul_f32 v[38:39], v[26:27], s[44:45]
    v_pk_mul_f32 v[62:63], v[28:29], s[44:45]
    v_pk_mul_f32 v[126:127], v[30:31], s[44:45]
    v_exp_f32 v36, v36
    v_exp_f32 v37, v37
    v_exp_f32 v38, v38
    v_exp_f32 v39, v39
    v_exp_f32 v62, v62
    v_exp_f32 v63, v63
    v_exp_f32 v126, v126
    v_exp_f32 v127, v127
    s_nop 0
    v_pk_add_f32 v[36:37], v[36:37], 1.0 op_sel_hi:[1,0]
    v_pk_add_f32 v[38:39], v[38:39], 1.0 op_sel_hi:[1,0]
    v_pk_add_f32 v[62:63], v[62:63], 1.0 op_sel_hi:[1,0]
    v_pk_add_f32 v[126:127], v[126:127], 1.0 op_sel_hi:[1,0]
    v_rcp_f32 v36, v36
    v_rcp_f32 v37, v37
    v_rcp_f32 v38, v38
    v_rcp_f32 v39, v39
    v_rcp_f32 v62, v62
    v_rcp_f32 v63, v63
    v_rcp_f32 v126, v126
    v_rcp_f32 v127, v127
    s_nop 0
    v_pk_mul_f32 v[24:25], v[24:25], v[36:37]
    v_pk_mul_f32 v[26:27], v[26:27], v[38:39]
    v_pk_mul_f32 v[28:29], v[28:29], v[62:63]
    v_pk_mul_f32 v[30:31], v[30:31], v[126:127]
    v_pk_mul_f32 v[62:63], v[24:25], v[104:105]
    v_pk_fma_f32 v[62:63], v[26:27], v[106:107], v[62:63]
    v_pk_fma_f32 v[62:63], v[28:29], v[108:109], v[62:63]
    v_pk_fma_f32 v[62:63], v[30:31], v[110:111], v[62:63]
    v_add_f32 v62, v62, v63
    v_lshlrev_b32 v63, 16, v60
    v_and_b32 v126, 0xffff0000, v60
    v_lshlrev_b32 v127, 16, v61
    s_mov_b64 exec, s[54:55]
    v_pk_add_f32 v[112:113], v[112:113], v[24:25]
    v_pk_add_f32 v[114:115], v[114:115], v[26:27]
    v_pk_add_f32 v[116:117], v[116:117], v[28:29]
    v_pk_add_f32 v[118:119], v[118:119], v[30:31]
    v_fmac_f32 v120, v62, v63
    v_fmac_f32 v121, v62, v126
    v_fmac_f32 v56, v62, v127
    s_mov_b64 exec, -1
    s_add_u32 s51, s51, 8
    s_cmp_lt_u32 s51, s50
    s_cbranch_scc1 ILOOP
N_end:
    s_waitcnt vmcnt(0)
    s_nop 1
    v_add_f32_dpp v120, v120, v120 row_ror:8 row_mask:0xf bank_mask:0xf
    v_add_f32_dpp v121, v121, v121 row_ror:8 row_mask:0xf bank_mask:0xf
    v_add_f32_dpp v56, v56, v56 row_ror:8 row_mask:0xf bank_mask:0xf
    s_nop 1
    v_add_f32_dpp v120, v120, v120 row_ror:4 row_mask:0xf bank_mask:0xf
    v_add_f32_dpp v121, v121, v121 row_ror:4 row_mask:0xf bank_mask:0xf
    v_add_f32_dpp v56, v56, v56 row_ror:4 row_mask:0xf bank_mask:0xf
    s_nop 1
    v_add_f32_dpp v120, v120, v120 row_ror:2 row_mask:0xf bank_mask:0xf
    v_add_f32_dpp v121, v121, v121 row_ror:2 row_mask:0xf bank_mask:0xf
    v_add_f32_dpp v56, v56, v56 row_ror:2 row_mask:0xf bank_mask:0xf
    s_nop 1
    v_add_f32_dpp v120, v120, v120 row_ror:1 row_mask:0xf bank_mask:0xf
    v_add_f32_dpp v121, v121, v121 row_ror:1 row_mask:0xf bank_mask:0xf
    v_add_f32_dpp v56, v56, v56 row_ror:1 row_mask:0xf bank_mask:0xf
    v_cmp_eq_u32 vcc, 1, v3
    s_nop 1
    v_cndmask_b32 v120, v120, v121, vcc
    v_cmp_eq_u32 vcc, 2, v3
    s_nop 1
    v_cndmask_b32 v120, v120, v56, vcc
    v_xor_b32 v16, 16, v2
    v_lshlrev_b32 v16, 2, v16
    ds_bpermute_b32 v24, v16, v112
    ds_bpermute_b32 v25, v16, v113
    ds_bpermute_b32 v26, v16, v114
    ds_bpermute_b32 v27, v16, v115
    ds_bpermute_b32 v28, v16, v116
    ds_bpermute_b32 v29, v16, v117
    ds_bpermute_b32 v30, v16, v118
    ds_bpermute_b32 v31, v16, v119
    ds_bpermute_b32 v32, v16, v120
    s_waitcnt lgkmcnt(0)
    v_add_f32 v112, v112, v24
    v_add_f32 v113, v113, v25
    v_add_f32 v114, v114, v26
    v_add_f32 v115, v115, v27
    v_add_f32 v116, v116, v28
    v_add_f32 v117, v117, v29
    v_add_f32 v118, v118, v30
    v_add_f32 v119, v119, v31
    v_add_f32 v120, v120, v32
    v_xor_b32 v16, 32, v2
    v_lshlrev_b32 v16, 2, v16
    ds_bpermute_b32 v24, v16, v112
    ds_bpermute_b32 v25, v16, v113
    ds_bpermute_b32 v26, v16, v114
    ds_bpermute_b32 v27, v16, v115
    ds_bpermute_b32 v28, v16, v116
    ds_bpermute_b32 v29, v16, v117
    ds_bpermute_b32 v30, v16, v118
    ds_bpermute_b32 v31, v16, v119
    ds_bpermute_b32 v32, v16, v120
    s_waitcnt lgkmcnt(0)
    v_add_f32 v112, v112, v24
    v_add_f32 v113, v113, v25
    v_add_f32 v114, v114, v26
    v_add_f32 v115, v115, v27
    v_add_f32 v116, v116, v28
    v_add_f32 v117, v117, v29
    v_add_f32 v118, v118, v30
    v_add_f32 v119, v119, v31
    v_add_f32 v120, v120, v32
    v_cmp_gt_u32 vcc, 16, v2
    s_and_b64 exec, exec, vcc
    s_mul_i32 s3, s48, 512
    v_lshl_add_u32 v15, v7, 1, s3
    ds_read_b128 v[24:27], v15 offset:24576
    ds_read_b128 v[28:31], v15 offset:24592
    s_lshl_b32 s3, s48, 4
    v_lshl_add_u32 v16, v3, 2, s3
    ds_read_b32 v17, v16 offset:45056
    s_waitcnt lgkmcnt(0)
    v_pk_add_f32 v[112:113], v[112:113], v[24:25]
    v_pk_add_f32 v[114:115], v[114:115], v[26:27]
    v_pk_add_f32 v[116:117], v[116:117], v[28:29]
    v_pk_add_f32 v[118:119], v[118:119], v[30:31]
    v_add_f32 v120, v120, v17
    ds_write_b128 v15, v[112:115] offset:24576
    ds_write_b128 v15, v[116:119] offset:24592
    v_cmp_gt_u32 vcc, 3, v3
    s_and_b64 exec, exec, vcc
    ds_write_b32 v16, v120 offset:45056
    s_mov_b64 exec, -1
    s_branch NLOOP
E_done:
    s_waitcnt lgkmcnt(0)
    s_barrier
    s_cmp_eq_u32 s39, 0
    s_cbranch_scc1 NODE
    v_mov_b32 v16, 0
    v_mov_b32 v17, 0
    v_mov_b32 v14, 45824
    ds_write_b64 v14, v[16:17]
    s_mov_b32 s60, 1
    s_branch PASS
NODE:
    s_and_b32 s3, s37, 7
    s_lshl_b32 s3, s3, 4
    v_add_u32 v12, s3, v3
    v_lshlrev_b32 v12, 9, v12
    v_lshl_add_u32 v12, v4, 4, v12
    v_add_u32 v12, 2654208, v12
    global_load_dwordx4 v[64:67], v12, s[32:33] offset:0
    global_load_dwordx4 v[68:71], v12, s[32:33] offset:64
    global_load_dwordx4 v[72:75], v12, s[32:33] offset:128
    global_load_dwordx4 v[76:79], v12, s[32:33] offset:192
    global_load_dwordx4 v[80:83], v12, s[32:33] offset:256
    global_load_dwordx4 v[84:87], v12, s[32:33] offset:320
    global_load_dwordx4 v[88:91], v12, s[32:33] offset:384
    global_load_dwordx4 v[92:95], v12, s[32:33] offset:448
    s_mov_b32 s61, 0
    s_cmp_lt_u32 s37, 8
    s_cbranch_scc1 NT
    s_mov_b32 s61, 32
NT:
    v_add_u32 v13, s61, v3
    v_add_u32 v13, s36, v13
    v_min_u32 v15, 9999, v13
    v_lshlrev_b32 v15, 8, v15
    v_lshl_add_u32 v14, v4, 4, v15
    global_load_dwordx4 v[16:19], v14, s[16:17] offset:0
    global_load_dwordx4 v[20:23], v14, s[16:17] offset:64
    global_load_dwordx4 v[24:27], v14, s[16:17] offset:128
    global_load_dwordx4 v[28:31], v14, s[16:17] offset:192
    s_lshl_b32 s4, s3, 1
    v_lshl_add_u32 v15, v4, 3, v15
    v_add_u32 v15, s4, v15
    global_load_dwordx2 v[56:57], v15, s[16:17]
    v_add_u32 v14, s61, v3
    v_min_u32 v14, 39, v14
    v_lshlrev_b32 v14, 9, v14
    v_lshl_add_u32 v14, v4, 5, v14
    ds_read_b128 v[96:99], v14 offset:24576
    ds_read_b128 v[100:103], v14 offset:24592
    ds_read_b128 v[104:107], v14 offset:24704
    ds_read_b128 v[108:111], v14 offset:24720
    ds_read_b128 v[112:115], v14 offset:24832
    ds_read_b128 v[116:119], v14 offset:24848
    ds_read_b128 v[120:123], v14 offset:24960
    ds_read_b128 v[124:127], v14 offset:24976
    s_waitcnt lgkmcnt(0)
    v_cvt_pk_bf16_f32 v32, v96, v97
    v_cvt_pk_bf16_f32 v33, v98, v99
    v_cvt_pk_bf16_f32 v34, v100, v101
    v_cvt_pk_bf16_f32 v35, v102, v103
    v_cvt_pk_bf16_f32 v36, v104, v105
    v_cvt_pk_bf16_f32 v37, v106, v107
    v_cvt_pk_bf16_f32 v38, v108, v109
    v_cvt_pk_bf16_f32 v39, v110, v111
    v_cvt_pk_bf16_f32 v40, v112, v113
    v_cvt_pk_bf16_f32 v41, v114, v115
    v_cvt_pk_bf16_f32 v42, v116, v117
    v_cvt_pk_bf16_f32 v43, v118, v119
    v_cvt_pk_bf16_f32 v44, v120, v121
    v_cvt_pk_bf16_f32 v45, v122, v123
    v_cvt_pk_bf16_f32 v46, v124, v125
    v_cvt_pk_bf16_f32 v47, v126, v127
    s_waitcnt vmcnt(0)
    s_nop 1
    v_mfma_f32_16x16x32_bf16 v[48:51], v[64:67], v[16:19], 0
    v_mfma_f32_16x16x32_bf16 v[48:51], v[68:71], v[20:23], v[48:51]
    v_mfma_f32_16x16x32_bf16 v[48:51], v[72:75], v[24:27], v[48:51]
    v_mfma_f32_16x16x32_bf16 v[48:51], v[76:79], v[28:31], v[48:51]
    v_mfma_f32_16x16x32_bf16 v[48:51], v[80:83], v[32:35], v[48:51]
    v_mfma_f32_16x16x32_bf16 v[48:51], v[84:87], v[36:39], v[48:51]
    v_mfma_f32_16x16x32_bf16 v[48:51], v[88:91], v[40:43], v[48:51]
    v_mfma_f32_16x16x32_bf16 v[48:51], v[92:95], v[44:47], v[48:51]
    s_nop 7
    v_cvt_pk_bf16_f32 v48, v48, v48
    v_and_b32 v48, 0xffff0000, v48
    v_mul_f32 v52, s44, v48
    v_exp_f32 v52, v52
    s_nop 0
    v_add_f32 v52, 1.0, v52
    v_rcp_f32 v52, v52
    s_nop 0
    v_mul_f32 v48, v48, v52
    v_cvt_pk_bf16_f32 v48, v48, v48
    v_and_b32 v48, 0xffff0000, v48
    v_cvt_pk_bf16_f32 v49, v49, v49
    v_and_b32 v49, 0xffff0000, v49
    v_mul_f32 v53, s44, v49
    v_exp_f32 v53, v53
    s_nop 0
    v_add_f32 v53, 1.0, v53
    v_rcp_f32 v53, v53
    s_nop 0
    v_mul_f32 v49, v49, v53
    v_cvt_pk_bf16_f32 v49, v49, v49
    v_and_b32 v49, 0xffff0000, v49
    v_cvt_pk_bf16_f32 v50, v50, v50
    v_and_b32 v50, 0xffff0000, v50
    v_mul_f32 v54, s44, v50
    v_exp_f32 v54, v54
    s_nop 0
    v_add_f32 v54, 1.0, v54
    v_rcp_f32 v54, v54
    s_nop 0
    v_mul_f32 v50, v50, v54
    v_cvt_pk_bf16_f32 v50, v50, v50
    v_and_b32 v50, 0xffff0000, v50
    v_cvt_pk_bf16_f32 v51, v51, v51
    v_and_b32 v51, 0xffff0000, v51
    v_mul_f32 v55, s44, v51
    v_exp_f32 v55, v55
    s_nop 0
    v_add_f32 v55, 1.0, v55
    v_rcp_f32 v55, v55
    s_nop 0
    v_mul_f32 v51, v51, v55
    v_cvt_pk_bf16_f32 v51, v51, v51
    v_and_b32 v51, 0xffff0000, v51
    v_lshlrev_b32 v52, 16, v56
    v_and_b32 v53, 0xffff0000, v56
    v_lshlrev_b32 v54, 16, v57
    v_and_b32 v55, 0xffff0000, v57
    v_add_f32 v48, v48, v52
    v_add_f32 v49, v49, v53
    v_add_f32 v50, v50, v54
    v_add_f32 v51, v51, v55
    v_cvt_pk_bf16_f32 v48, v48, v49
    v_cvt_pk_bf16_f32 v49, v50, v51
    v_add_u32 v14, s61, v3
    v_cmp_gt_u32 vcc, 40, v14
    s_and_saveexec_b64 s[6:7], vcc
    global_store_dwordx2 v15, v[48:49], s[34:35]
    s_mov_b64 exec, s[6:7]
    s_cmp_lg_u32 s61, 0
    s_cbranch_scc1 POSO
    s_mov_b32 s61, 16
    s_branch NT
POSO:
    s_cmp_lt_u32 s37, 8
    s_cbranch_scc1 K2_end
    s_cmp_ge_u32 s37, 10
    s_cbranch_scc1 K2_end
    v_subrev_u32 v12, 512, v0
    v_cmp_gt_u32 vcc, 120, v12
    s_and_saveexec_b64 s[6:7], vcc
    s_cbranch_execz K2_end
    v_mul_u32_u24 v13, 0x5556, v12
    v_lshrrev_b32 v13, 16, v13
    v_add_u32 v14, v12, v13
    v_lshlrev_b32 v14, 2, v14
    ds_read_b32 v15, v14 offset:45056
    s_mul_i32 s3, s36, 3
    v_add_u32 v12, s3, v12
    v_lshlrev_b32 v12, 1, v12
    global_load_ushort v16, v12, s[18:19]
    s_waitcnt vmcnt(0) lgkmcnt(0)
    v_cvt_pk_bf16_f32 v15, v15, v15
    v_and_b32 v15, 0xffff0000, v15
    v_lshlrev_b32 v16, 16, v16
    v_add_f32 v16, v16, v15
    v_cvt_pk_bf16_f32 v16, v16, v16
    v_add_u32 v12, 2560000, v12
    global_store_short v12, v16, s[34:35]
K2_end:
    s_endpgm
.section .rodata,"a"
.p2align 6
.amdhsa_kernel k1_kernel
  .amdhsa_next_free_vgpr 144
  .amdhsa_next_free_sgpr 64
  .amdhsa_accum_offset 144
  .amdhsa_group_segment_fixed_size 0
  .amdhsa_kernarg_size 88
  .amdhsa_user_sgpr_count 2
  .amdhsa_user_sgpr_kernarg_segment_ptr 1
  .amdhsa_system_sgpr_workgroup_id_x 1
  .amdhsa_float_denorm_mode_32 3
.end_amdhsa_kernel
.p2align 6
.amdhsa_kernel k2_kernel
  .amdhsa_next_free_vgpr 128
  .amdhsa_next_free_sgpr 64
  .amdhsa_accum_offset 128
  .amdhsa_group_segment_fixed_size 0
  .amdhsa_kernarg_size 88
  .amdhsa_user_sgpr_count 2
  .amdhsa_user_sgpr_kernarg_segment_ptr 1
  .amdhsa_system_sgpr_workgroup_id_x 1
  .amdhsa_float_denorm_mode_32 3
.end_amdhsa_kernel
```
